```python
import torch

def _softmax(x, axis=-1):
    return torch.softmax(x, dim=axis)
def _gelu(x):
    return torch.nn.functional.gelu(x, approximate="tanh")
def _silu(x):
    return torch.nn.functional.silu(x)
def _sigmoid(x):
    return torch.sigmoid(x)
def _layernorm(x, axis=-1, eps=1e-5):
    m = x.mean(dim=axis, keepdim=True)
    v = x.var(dim=axis, keepdim=True, unbiased=False)
    return (x - m) / torch.sqrt(v + eps)
def _scatter_add(tgt, idx, src, axis=0):
    return tgt.clone().index_add_(axis, idx, src)
def _segment_sum(src, seg, n):
    out = torch.zeros((n,) + src.shape[1:], dtype=src.dtype)
    return out.index_add_(0, seg, src)
def _pad(x, pw):
    flat = tuple(v for pair in reversed(pw) for v in pair)
    return torch.nn.functional.pad(x, flat)

kernel_name = 'standalone__paged_block_table_kv_pagedattention__sampling'

def setup_inputs():

    _w = (lambda a: (lambda t: t.to(torch.bfloat16) if t.is_floating_point() else t)(torch.as_tensor(a)))
    B, Hq, Hkv, Sq, Skv, D = 16, 32, 4, 8, 4096, 128
    bs = 16
    nbps = max(1, Skv // bs)
    num_phys = B * nbps + 4
    bt = torch.randperm(num_phys)[: B * nbps].reshape(B, nbps).to(torch.int64)
    cl = (nbps * bs - (torch.arange(1, B + 1, dtype=torch.int64) * 2654435761) % max(1, nbps * bs // 2)).to(torch.int64)
    return {
        "q": _w((lambda *s: torch.randn(*s, dtype=torch.bfloat16) * 0.8)(B, Hq, Sq, D)),
        "k_cache": _w((lambda *s: torch.randn(*s, dtype=torch.bfloat16) * 0.8)(num_phys, bs, Hkv, D)),
        "v_cache": _w((lambda *s: torch.randn(*s, dtype=torch.bfloat16) * 0.05)(num_phys, bs, Hkv, D)),
        "block_table": _w(bt),
        "context_lens": _w(cl),
    }

def reference(q, k_cache, v_cache, block_table, context_lens):
    B, Hq, Sq, D = q.shape
    bs = k_cache.shape[1]
    Hkv = k_cache.shape[2]
    nbps = block_table.shape[1]
    Skv = nbps * bs
    bt = block_table.reshape(-1)
    k = (lambda x, *d: x.permute(*d))(k_cache[bt].reshape(B, Skv, Hkv, D), 0, 2, 1, 3)
    v = (lambda x, *d: x.permute(*d))(v_cache[bt].reshape(B, Skv, Hkv, D), 0, 2, 1, 3)
    g = Hq // Hkv
    qg = q.reshape(B, Hkv, g, Sq, D)
    scores = torch.einsum("bhgqd,bhkd->bhgqk", qg, k) * (D ** -0.5)
    pos = torch.arange(Skv)
    msk = pos[None, :] < context_lens[:, None]
    scores = torch.where(msk[:, None, None, None, :], scores, -1e9)
    p = _softmax(scores, axis=-1)
    out = torch.einsum("bhgqk,bhkd->bhgqd", p, v)
    return out.reshape(B, Hq, Sq, D)
```

```asm
; @launch kernel=standalone__paged_block_table_kv_pagedattention__sampling_kernel grid=(512,1,1) block=(256,1,1) lds=65536
; @launch kernel=standalone__paged_block_table_kv_pagedattention__sampling_combine_kernel grid=(256,1,1) block=(256,1,1) lds=0
.amdgcn_target "amdgcn-amd-amdhsa--gfx950"
.text
.globl standalone__paged_block_table_kv_pagedattention__sampling_kernel
.p2align 8
.type standalone__paged_block_table_kv_pagedattention__sampling_kernel,@function
standalone__paged_block_table_kv_pagedattention__sampling_kernel:
    s_load_dwordx16 s[4:19], s[0:1], 0
    v_and_b32 v157, 63, v0
    v_lshrrev_b32 v153, 6, v0
    v_and_b32 v154, 15, v0
    v_readfirstlane_b32 s36, v153
    v_lshlrev_b32 v153, 2, v154
    s_waitcnt lgkmcnt(0)
    s_mov_b32 s24, s12
    s_and_b32 s25, s13, 0xffff
    s_mov_b32 s26, 64
    s_mov_b32 s27, 0x20000
    buffer_load_dword v56, v153, s[24:27], 0 offen
    s_and_b32 s53, s36, 1
    s_cmp_eq_u32 s53, 0
    s_cselect_b32 s20, s6, s8
    s_cselect_b32 s21, s7, s9
    s_and_b32 s21, s21, 0xffff
    s_mov_b32 s22, 67174400
    s_mov_b32 s23, 0x20000
    s_mov_b32 s28, s4
    s_and_b32 s29, s5, 0xffff
    s_mov_b32 s30, 1048576
    s_mov_b32 s31, 0x20000
    s_mov_b32 s32, s18
    s_and_b32 s33, s19, 0xffff
    s_mov_b32 s34, 268697600
    s_mov_b32 s35, 0x20000
    s_lshr_b32 s59, s36, 1
    s_lshl_b32 s52, s53, 13
    s_lshl_b32 s54, s59, 12
    s_add_u32 s52, s52, s54
    v_lshrrev_b32 v153, 4, v157
    v_add_u32 v159, 0, v153
    v_xor_b32 v159, v159, v154
    v_lshlrev_b32 v159, 4, v159
    v_lshl_add_u32 v132, v154, 8, v159
    v_add_u32 v159, 4, v153
    v_xor_b32 v159, v159, v154
    v_lshlrev_b32 v159, 4, v159
    v_lshl_add_u32 v133, v154, 8, v159
    v_add_u32 v159, 8, v153
    v_xor_b32 v159, v159, v154
    v_lshlrev_b32 v159, 4, v159
    v_lshl_add_u32 v134, v154, 8, v159
    v_add_u32 v159, 12, v153
    v_xor_b32 v159, v159, v154
    v_lshlrev_b32 v159, 4, v159
    v_lshl_add_u32 v135, v154, 8, v159
    v_lshrrev_b32 v155, 2, v154
    v_lshl_add_u32 v155, v153, 2, v155
    v_and_b32 v156, 7, v155
    v_and_b32 v150, 3, v154
    v_lshlrev_b32 v150, 3, v150
    v_lshl_add_u32 v150, v155, 8, v150
    v_xor_b32 v159, 0, v156
    v_lshl_add_u32 v136, v159, 5, v150
    v_xor_b32 v159, 1, v156
    v_lshl_add_u32 v137, v159, 5, v150
    v_xor_b32 v159, 2, v156
    v_lshl_add_u32 v138, v159, 5, v150
    v_xor_b32 v159, 3, v156
    v_lshl_add_u32 v139, v159, 5, v150
    v_xor_b32 v159, 4, v156
    v_lshl_add_u32 v140, v159, 5, v150
    v_xor_b32 v159, 5, v156
    v_lshl_add_u32 v141, v159, 5, v150
    v_xor_b32 v159, 6, v156
    v_lshl_add_u32 v142, v159, 5, v150
    v_xor_b32 v159, 7, v156
    v_lshl_add_u32 v143, v159, 5, v150
    v_lshlrev_b32 v149, 2, v153
    s_cmp_eq_u32 s53, 0
    s_cselect_b32 s54, 0, 1
    v_add_u32 v159, 0, v153
    v_and_b32 v155, 7, v159
    v_lshlrev_b32 v155, 1, v155
    v_cmp_eq_u32_e64 vcc, 0, s54
    s_nop 1
    v_cndmask_b32 v155, v155, v159, vcc
    v_xor_b32 v155, v155, v154
    v_lshlrev_b32 v155, 4, v155
    v_lshl_add_u32 v155, v159, 10, v155
    v_subrev_u32 v144, 0, v155
    v_add_u32 v159, 4, v153
    v_and_b32 v155, 7, v159
    v_lshlrev_b32 v155, 1, v155
    v_cmp_eq_u32_e64 vcc, 0, s54
    s_nop 1
    v_cndmask_b32 v155, v155, v159, vcc
    v_xor_b32 v155, v155, v154
    v_lshlrev_b32 v155, 4, v155
    v_lshl_add_u32 v155, v159, 10, v155
    v_subrev_u32 v145, 1024, v155
    v_add_u32 v159, 8, v153
    v_and_b32 v155, 7, v159
    v_lshlrev_b32 v155, 1, v155
    v_cmp_eq_u32_e64 vcc, 0, s54
    s_nop 1
    v_cndmask_b32 v155, v155, v159, vcc
    v_xor_b32 v155, v155, v154
    v_lshlrev_b32 v155, 4, v155
    v_lshl_add_u32 v155, v159, 10, v155
    v_subrev_u32 v146, 2048, v155
    v_add_u32 v159, 12, v153
    v_and_b32 v155, 7, v159
    v_lshlrev_b32 v155, 1, v155
    v_cmp_eq_u32_e64 vcc, 0, s54
    s_nop 1
    v_cndmask_b32 v155, v155, v159, vcc
    v_xor_b32 v155, v155, v154
    v_lshlrev_b32 v155, 4, v155
    v_lshl_add_u32 v155, v159, 10, v155
    v_subrev_u32 v147, 3072, v155
    v_lshlrev_b32 v155, 4, v153
    v_lshl_add_u32 v158, v154, 8, v155
    s_waitcnt vmcnt(0)
    v_mov_b32 v57, 0x1000
    v_min_i32 v62, v56, v57
    v_cmp_lt_i32 vcc, 0, v56
    s_nop 1
    v_cndmask_b32 v57, v57, v62, vcc
    v_add_u32 v58, 31, v57
    v_lshrrev_b32 v58, 5, v58
    v_mov_b32 v61, v58
    s_nop 1
    v_add_u32_dpp v61, v61, v61 row_shr:1 row_mask:0xf bank_mask:0xf bound_ctrl:0
    s_nop 1
    v_add_u32_dpp v61, v61, v61 row_shr:2 row_mask:0xf bank_mask:0xf bound_ctrl:0
    s_nop 1
    v_add_u32_dpp v61, v61, v61 row_shr:4 row_mask:0xf bank_mask:0xf bound_ctrl:0
    s_nop 1
    v_add_u32_dpp v61, v61, v61 row_shr:8 row_mask:0xf bank_mask:0xf bound_ctrl:0
    s_nop 1
    v_readlane_b32 s45, v61, 15
    s_nop 3
    s_lshl_b32 s45, s45, 2
    s_add_u32 s53, s45, 447
    s_mov_b32 s44, 9586981
    s_mul_hi_u32 s44, s53, s44
    v_cvt_f32_u32 v63, s44
    v_rcp_f32 v63, v63
    v_add_u32 v62, s44, v58
    v_cvt_f32_u32 v62, v62
    v_add_f32 v62, -0.5, v62
    v_mul_f32 v62, v62, v63
    v_cvt_u32_f32 v59, v62
    v_lshlrev_b32 v61, 2, v59
    s_nop 1
    v_add_u32_dpp v61, v61, v61 row_shr:1 row_mask:0xf bank_mask:0xf bound_ctrl:0
    s_nop 1
    v_add_u32_dpp v61, v61, v61 row_shr:2 row_mask:0xf bank_mask:0xf bound_ctrl:0
    s_nop 1
    v_add_u32_dpp v61, v61, v61 row_shr:4 row_mask:0xf bank_mask:0xf bound_ctrl:0
    s_nop 1
    v_add_u32_dpp v61, v61, v61 row_shr:8 row_mask:0xf bank_mask:0xf bound_ctrl:0
    v_lshlrev_b32 v62, 2, v59
    v_sub_u32 v60, v61, v62
    s_nop 0
    v_readlane_b32 s46, v61, 15
    s_nop 3
    s_cmp_ge_u32 s2, s46
    s_cbranch_scc1 K1_EXIT
    v_cmp_ge_u32 vcc, s2, v60
    s_nop 3
    s_and_b32 s53, vcc_lo, 0xffff
    s_bcnt1_i32_b32 s53, s53
    s_sub_u32 s37, s53, 1
    s_nop 3
    v_readlane_b32 s42, v58, s37
    v_readlane_b32 s43, v57, s37
    v_readlane_b32 s56, v60, s37
    v_readlane_b32 s55, v56, s37
    s_nop 3
    s_sub_u32 s53, s2, s56
    s_and_b32 s38, s53, 3
    s_lshr_b32 s39, s53, 2
    s_mul_i32 s40, s39, s44
    s_sub_u32 s41, s42, s40
    s_min_u32 s41, s41, s44
    s_sub_u32 s54, s42, 1
    s_lshl_b32 s54, s54, 5
    s_sub_u32 s54, s43, s54
    s_add_u32 s53, s40, s41
    s_cmp_eq_u32 s53, s42
    s_cselect_b32 s47, s54, 32
    s_mov_b32 s48, 0x3e0293ee
    s_cmp_gt_i32 s55, 0
    s_cselect_b32 s48, s48, 0
    s_mov_b32 s24, s10
    s_and_b32 s25, s11, 0xffff
    s_mov_b32 s26, 16384
    s_mov_b32 s27, 0x20000
    v_add_u32 v153, s40, v157
    v_lshlrev_b32 v153, 1, v153
    v_add_u32 v153, s59, v153
    s_lshl_b32 s53, s37, 8
    v_add_u32 v154, s53, v153
    v_lshlrev_b32 v154, 2, v154
    buffer_load_dword v148, v154, s[24:27], 0 offen
    s_lshl_b32 s53, s37, 2
    s_add_u32 s53, s53, s38
    s_lshl_b32 s53, s53, 6
    s_lshl_b32 s54, s36, 4
    s_add_u32 s53, s53, s54
    s_lshl_b32 s58, s53, 8
    buffer_load_dwordx4 v[8:11], v158, s[28:31], s58 offen offset:0
    buffer_load_dwordx4 v[12:15], v158, s[28:31], s58 offen offset:64
    buffer_load_dwordx4 v[16:19], v158, s[28:31], s58 offen offset:128
    buffer_load_dwordx4 v[20:23], v158, s[28:31], s58 offen offset:192
    v_lshlrev_b32 v153, 4, v153
    v_cmp_gt_u32 vcc, s43, v153
    v_cmp_gt_u32 s[60:61], s41, v157
    s_nop 1
    s_and_b64 vcc, vcc, s[60:61]
    s_lshl_b32 s53, s38, 8
    v_mov_b32 v154, 67174400
    s_waitcnt vmcnt(4)
    v_lshlrev_b32 v148, 14, v148
    v_add_u32 v148, s53, v148
    v_cndmask_b32 v148, v154, v148, vcc
    v_mov_b32 v24, 0
    v_mov_b32 v25, 0
    v_mov_b32 v26, 0
    v_mov_b32 v27, 0
    v_mov_b32 v28, 0
    v_mov_b32 v29, 0
    v_mov_b32 v30, 0
    v_mov_b32 v31, 0
    v_mov_b32 v32, 0
    v_mov_b32 v33, 0
    v_mov_b32 v34, 0
    v_mov_b32 v35, 0
    v_mov_b32 v36, 0
    v_mov_b32 v37, 0
    v_mov_b32 v38, 0
    v_mov_b32 v39, 0
    v_mov_b32 v40, 0
    v_mov_b32 v41, 0
    v_mov_b32 v42, 0
    v_mov_b32 v43, 0
    v_mov_b32 v44, 0
    v_mov_b32 v45, 0
    v_mov_b32 v46, 0
    v_mov_b32 v47, 0
    v_mov_b32 v48, 0
    v_mov_b32 v49, 0
    v_mov_b32 v50, 0
    v_mov_b32 v51, 0
    v_mov_b32 v52, 0
    v_mov_b32 v53, 0
    v_mov_b32 v54, 0
    v_mov_b32 v55, 0
    v_mov_b32 v150, 0xff800000
    v_mov_b32 v151, 0xff800000
    v_mov_b32 v152, 0
    s_mov_b32 s49, 0
    s_mov_b32 s50, 0
    v_readlane_b32 s51, v148, s49
    s_add_u32 m0, s52, 0
    s_add_u32 s49, s49, 1
    s_nop 2
    buffer_load_dwordx4 v144, s[20:23], s51 offen offset:0 nt lds
    buffer_load_dwordx4 v145, s[20:23], s51 offen offset:1024 nt lds
    buffer_load_dwordx4 v146, s[20:23], s51 offen offset:2048 nt lds
    buffer_load_dwordx4 v147, s[20:23], s51 offen offset:3072 nt lds
    v_readlane_b32 s51, v148, s49
    s_add_u32 m0, s52, 16384
    s_add_u32 s49, s49, 1
    s_nop 2
    buffer_load_dwordx4 v144, s[20:23], s51 offen offset:0 nt lds
    buffer_load_dwordx4 v145, s[20:23], s51 offen offset:1024 nt lds
    buffer_load_dwordx4 v146, s[20:23], s51 offen offset:2048 nt lds
    buffer_load_dwordx4 v147, s[20:23], s51 offen offset:3072 nt lds
    v_readlane_b32 s51, v148, s49
    s_add_u32 m0, s52, 32768
    s_add_u32 s49, s49, 1
    s_nop 2
    buffer_load_dwordx4 v144, s[20:23], s51 offen offset:0 nt lds
    buffer_load_dwordx4 v145, s[20:23], s51 offen offset:1024 nt lds
    buffer_load_dwordx4 v146, s[20:23], s51 offen offset:2048 nt lds
    buffer_load_dwordx4 v147, s[20:23], s51 offen offset:3072 nt lds
    s_waitcnt vmcnt(8)
K1_LOOP:
    s_waitcnt vmcnt(8)
    s_barrier
    v_readlane_b32 s51, v148, s49
    s_add_u32 m0, s52, 49152
    s_add_u32 s49, s49, 1
    s_nop 2
    buffer_load_dwordx4 v144, s[20:23], s51 offen offset:0 nt lds
    buffer_load_dwordx4 v145, s[20:23], s51 offen offset:1024 nt lds
    buffer_load_dwordx4 v146, s[20:23], s51 offen offset:2048 nt lds
    buffer_load_dwordx4 v147, s[20:23], s51 offen offset:3072 nt lds
    ds_read_b128 v[56:59], v132 offset:0
    ds_read_b128 v[60:63], v133 offset:0
    ds_read_b128 v[64:67], v134 offset:0
    ds_read_b128 v[68:71], v135 offset:0
    ds_read_b128 v[72:75], v132 offset:4096
    ds_read_b128 v[76:79], v133 offset:4096
    ds_read_b128 v[80:83], v134 offset:4096
    ds_read_b128 v[84:87], v135 offset:4096
    s_add_u32 s50, s50, 1
    s_cmp_eq_u32 s50, s41
    s_cselect_b32 s57, s47, 32
    s_waitcnt lgkmcnt(0)
    v_mfma_f32_16x16x32_bf16 v[120:123], v[56:59], v[8:11], 0
    v_mfma_f32_16x16x32_bf16 v[124:127], v[72:75], v[8:11], 0
    v_mfma_f32_16x16x32_bf16 v[120:123], v[60:63], v[12:15], v[120:123]
    v_mfma_f32_16x16x32_bf16 v[124:127], v[76:79], v[12:15], v[124:127]
    v_mfma_f32_16x16x32_bf16 v[120:123], v[64:67], v[16:19], v[120:123]
    v_mfma_f32_16x16x32_bf16 v[124:127], v[80:83], v[16:19], v[124:127]
    v_mfma_f32_16x16x32_bf16 v[120:123], v[68:71], v[20:23], v[120:123]
    v_mfma_f32_16x16x32_bf16 v[124:127], v[84:87], v[20:23], v[124:127]
    ds_read_b64_tr_b16 v[88:89], v136 offset:8192
    ds_read_b64_tr_b16 v[90:91], v136 offset:12288
    ds_read_b64_tr_b16 v[92:93], v137 offset:8192
    ds_read_b64_tr_b16 v[94:95], v137 offset:12288
    ds_read_b64_tr_b16 v[96:97], v138 offset:8192
    ds_read_b64_tr_b16 v[98:99], v138 offset:12288
    ds_read_b64_tr_b16 v[100:101], v139 offset:8192
    ds_read_b64_tr_b16 v[102:103], v139 offset:12288
    ds_read_b64_tr_b16 v[104:105], v140 offset:8192
    ds_read_b64_tr_b16 v[106:107], v140 offset:12288
    ds_read_b64_tr_b16 v[108:109], v141 offset:8192
    ds_read_b64_tr_b16 v[110:111], v141 offset:12288
    ds_read_b64_tr_b16 v[112:113], v142 offset:8192
    ds_read_b64_tr_b16 v[114:115], v142 offset:12288
    ds_read_b64_tr_b16 v[116:117], v143 offset:8192
    ds_read_b64_tr_b16 v[118:119], v143 offset:12288
    s_cmp_lt_u32 s57, 32
    s_nop 7
    s_cbranch_scc0 K1_NOMASK_0
    s_sub_u32 s53, s57, 0
    v_mov_b32 v153, 0xff800000
    v_cmp_gt_i32 vcc, s53, v149
    s_nop 1
    v_cndmask_b32 v120, v153, v120, vcc
    s_sub_u32 s53, s57, 1
    v_mov_b32 v153, 0xff800000
    v_cmp_gt_i32 vcc, s53, v149
    s_nop 1
    v_cndmask_b32 v121, v153, v121, vcc
    s_sub_u32 s53, s57, 2
    v_mov_b32 v153, 0xff800000
    v_cmp_gt_i32 vcc, s53, v149
    s_nop 1
    v_cndmask_b32 v122, v153, v122, vcc
    s_sub_u32 s53, s57, 3
    v_mov_b32 v153, 0xff800000
    v_cmp_gt_i32 vcc, s53, v149
    s_nop 1
    v_cndmask_b32 v123, v153, v123, vcc
    s_sub_u32 s53, s57, 16
    v_mov_b32 v153, 0xff800000
    v_cmp_gt_i32 vcc, s53, v149
    s_nop 1
    v_cndmask_b32 v124, v153, v124, vcc
    s_sub_u32 s53, s57, 17
    v_mov_b32 v153, 0xff800000
    v_cmp_gt_i32 vcc, s53, v149
    s_nop 1
    v_cndmask_b32 v125, v153, v125, vcc
    s_sub_u32 s53, s57, 18
    v_mov_b32 v153, 0xff800000
    v_cmp_gt_i32 vcc, s53, v149
    s_nop 1
    v_cndmask_b32 v126, v153, v126, vcc
    s_sub_u32 s53, s57, 19
    v_mov_b32 v153, 0xff800000
    v_cmp_gt_i32 vcc, s53, v149
    s_nop 1
    v_cndmask_b32 v127, v153, v127, vcc
K1_NOMASK_0:
    v_max3_f32 v153, v120, v121, v122
    v_max3_f32 v154, v123, v124, v125
    v_max3_f32 v153, v153, v126, v127
    v_max3_f32 v153, v153, v154, v150
    v_mov_b32 v154, v153
    s_nop 1
    v_permlane16_swap_b32 v153, v154
    v_max_f32 v153, v153, v154
    v_mov_b32 v154, v153
    s_nop 1
    v_permlane32_swap_b32 v153, v154
    v_max_f32 v150, v153, v154
    v_mul_f32 v156, s48, v150
    v_sub_f32 v153, v151, v156
    v_exp_f32 v155, v153
    v_mov_b32 v151, v156
    v_fma_f32 v120, v120, s48, -v156
    v_fma_f32 v121, v121, s48, -v156
    v_fma_f32 v122, v122, s48, -v156
    v_fma_f32 v123, v123, s48, -v156
    v_fma_f32 v124, v124, s48, -v156
    v_fma_f32 v125, v125, s48, -v156
    v_fma_f32 v126, v126, s48, -v156
    v_fma_f32 v127, v127, s48, -v156
    v_exp_f32 v120, v120
    v_exp_f32 v121, v121
    v_exp_f32 v122, v122
    v_exp_f32 v123, v123
    v_exp_f32 v124, v124
    v_exp_f32 v125, v125
    v_exp_f32 v126, v126
    v_exp_f32 v127, v127
    v_mul_f32 v152, v152, v155
    v_add_f32 v153, v120, v121
    v_add_f32 v154, v122, v123
    v_add_f32 v159, v124, v125
    v_add_f32 v153, v153, v154
    v_add_f32 v154, v126, v127
    v_add_f32 v159, v159, v154
    v_add_f32 v153, v153, v159
    v_add_f32 v152, v152, v153
    v_cvt_pk_bf16_f32 v128, v120, v121
    v_cvt_pk_bf16_f32 v129, v122, v123
    v_cvt_pk_bf16_f32 v130, v124, v125
    v_cvt_pk_bf16_f32 v131, v126, v127
    v_mul_f32 v24, v24, v155
    v_mul_f32 v25, v25, v155
    v_mul_f32 v26, v26, v155
    v_mul_f32 v27, v27, v155
    v_mul_f32 v28, v28, v155
    v_mul_f32 v29, v29, v155
    v_mul_f32 v30, v30, v155
    v_mul_f32 v31, v31, v155
    v_mul_f32 v32, v32, v155
    v_mul_f32 v33, v33, v155
    v_mul_f32 v34, v34, v155
    v_mul_f32 v35, v35, v155
    v_mul_f32 v36, v36, v155
    v_mul_f32 v37, v37, v155
    v_mul_f32 v38, v38, v155
    v_mul_f32 v39, v39, v155
    v_mul_f32 v40, v40, v155
    v_mul_f32 v41, v41, v155
    v_mul_f32 v42, v42, v155
    v_mul_f32 v43, v43, v155
    v_mul_f32 v44, v44, v155
    v_mul_f32 v45, v45, v155
    v_mul_f32 v46, v46, v155
    v_mul_f32 v47, v47, v155
    v_mul_f32 v48, v48, v155
    v_mul_f32 v49, v49, v155
    v_mul_f32 v50, v50, v155
    v_mul_f32 v51, v51, v155
    v_mul_f32 v52, v52, v155
    v_mul_f32 v53, v53, v155
    v_mul_f32 v54, v54, v155
    v_mul_f32 v55, v55, v155
    s_waitcnt lgkmcnt(0)
    v_mfma_f32_16x16x32_bf16 v[24:27], v[88:91], v[128:131], v[24:27]
    v_mfma_f32_16x16x32_bf16 v[28:31], v[92:95], v[128:131], v[28:31]
    v_mfma_f32_16x16x32_bf16 v[32:35], v[96:99], v[128:131], v[32:35]
    v_mfma_f32_16x16x32_bf16 v[36:39], v[100:103], v[128:131], v[36:39]
    v_mfma_f32_16x16x32_bf16 v[40:43], v[104:107], v[128:131], v[40:43]
    v_mfma_f32_16x16x32_bf16 v[44:47], v[108:111], v[128:131], v[44:47]
    v_mfma_f32_16x16x32_bf16 v[48:51], v[112:115], v[128:131], v[48:51]
    v_mfma_f32_16x16x32_bf16 v[52:55], v[116:119], v[128:131], v[52:55]
    s_cmp_ge_u32 s50, s41
    s_cbranch_scc1 K1_DONE
    s_waitcnt vmcnt(8)
    s_barrier
    v_readlane_b32 s51, v148, s49
    s_add_u32 m0, s52, 0
    s_add_u32 s49, s49, 1
    s_nop 2
    buffer_load_dwordx4 v144, s[20:23], s51 offen offset:0 nt lds
    buffer_load_dwordx4 v145, s[20:23], s51 offen offset:1024 nt lds
    buffer_load_dwordx4 v146, s[20:23], s51 offen offset:2048 nt lds
    buffer_load_dwordx4 v147, s[20:23], s51 offen offset:3072 nt lds
    ds_read_b128 v[56:59], v132 offset:16384
    ds_read_b128 v[60:63], v133 offset:16384
    ds_read_b128 v[64:67], v134 offset:16384
    ds_read_b128 v[68:71], v135 offset:16384
    ds_read_b128 v[72:75], v132 offset:20480
    ds_read_b128 v[76:79], v133 offset:20480
    ds_read_b128 v[80:83], v134 offset:20480
    ds_read_b128 v[84:87], v135 offset:20480
    s_add_u32 s50, s50, 1
    s_cmp_eq_u32 s50, s41
    s_cselect_b32 s57, s47, 32
    s_waitcnt lgkmcnt(0)
    v_mfma_f32_16x16x32_bf16 v[120:123], v[56:59], v[8:11], 0
    v_mfma_f32_16x16x32_bf16 v[124:127], v[72:75], v[8:11], 0
    v_mfma_f32_16x16x32_bf16 v[120:123], v[60:63], v[12:15], v[120:123]
    v_mfma_f32_16x16x32_bf16 v[124:127], v[76:79], v[12:15], v[124:127]
    v_mfma_f32_16x16x32_bf16 v[120:123], v[64:67], v[16:19], v[120:123]
    v_mfma_f32_16x16x32_bf16 v[124:127], v[80:83], v[16:19], v[124:127]
    v_mfma_f32_16x16x32_bf16 v[120:123], v[68:71], v[20:23], v[120:123]
    v_mfma_f32_16x16x32_bf16 v[124:127], v[84:87], v[20:23], v[124:127]
    ds_read_b64_tr_b16 v[88:89], v136 offset:24576
    ds_read_b64_tr_b16 v[90:91], v136 offset:28672
    ds_read_b64_tr_b16 v[92:93], v137 offset:24576
    ds_read_b64_tr_b16 v[94:95], v137 offset:28672
    ds_read_b64_tr_b16 v[96:97], v138 offset:24576
    ds_read_b64_tr_b16 v[98:99], v138 offset:28672
    ds_read_b64_tr_b16 v[100:101], v139 offset:24576
    ds_read_b64_tr_b16 v[102:103], v139 offset:28672
    ds_read_b64_tr_b16 v[104:105], v140 offset:24576
    ds_read_b64_tr_b16 v[106:107], v140 offset:28672
    ds_read_b64_tr_b16 v[108:109], v141 offset:24576
    ds_read_b64_tr_b16 v[110:111], v141 offset:28672
    ds_read_b64_tr_b16 v[112:113], v142 offset:24576
    ds_read_b64_tr_b16 v[114:115], v142 offset:28672
    ds_read_b64_tr_b16 v[116:117], v143 offset:24576
    ds_read_b64_tr_b16 v[118:119], v143 offset:28672
    s_cmp_lt_u32 s57, 32
    s_nop 7
    s_cbranch_scc0 K1_NOMASK_1
    s_sub_u32 s53, s57, 0
    v_mov_b32 v153, 0xff800000
    v_cmp_gt_i32 vcc, s53, v149
    s_nop 1
    v_cndmask_b32 v120, v153, v120, vcc
    s_sub_u32 s53, s57, 1
    v_mov_b32 v153, 0xff800000
    v_cmp_gt_i32 vcc, s53, v149
    s_nop 1
    v_cndmask_b32 v121, v153, v121, vcc
    s_sub_u32 s53, s57, 2
    v_mov_b32 v153, 0xff800000
    v_cmp_gt_i32 vcc, s53, v149
    s_nop 1
    v_cndmask_b32 v122, v153, v122, vcc
    s_sub_u32 s53, s57, 3
    v_mov_b32 v153, 0xff800000
    v_cmp_gt_i32 vcc, s53, v149
    s_nop 1
    v_cndmask_b32 v123, v153, v123, vcc
    s_sub_u32 s53, s57, 16
    v_mov_b32 v153, 0xff800000
    v_cmp_gt_i32 vcc, s53, v149
    s_nop 1
    v_cndmask_b32 v124, v153, v124, vcc
    s_sub_u32 s53, s57, 17
    v_mov_b32 v153, 0xff800000
    v_cmp_gt_i32 vcc, s53, v149
    s_nop 1
    v_cndmask_b32 v125, v153, v125, vcc
    s_sub_u32 s53, s57, 18
    v_mov_b32 v153, 0xff800000
    v_cmp_gt_i32 vcc, s53, v149
    s_nop 1
    v_cndmask_b32 v126, v153, v126, vcc
    s_sub_u32 s53, s57, 19
    v_mov_b32 v153, 0xff800000
    v_cmp_gt_i32 vcc, s53, v149
    s_nop 1
    v_cndmask_b32 v127, v153, v127, vcc
K1_NOMASK_1:
    v_max3_f32 v153, v120, v121, v122
    v_max3_f32 v154, v123, v124, v125
    v_max3_f32 v153, v153, v126, v127
    v_max3_f32 v153, v153, v154, v150
    v_mov_b32 v154, v153
    s_nop 1
    v_permlane16_swap_b32 v153, v154
    v_max_f32 v153, v153, v154
    v_mov_b32 v154, v153
    s_nop 1
    v_permlane32_swap_b32 v153, v154
    v_max_f32 v150, v153, v154
    v_mul_f32 v156, s48, v150
    v_sub_f32 v153, v151, v156
    v_exp_f32 v155, v153
    v_mov_b32 v151, v156
    v_fma_f32 v120, v120, s48, -v156
    v_fma_f32 v121, v121, s48, -v156
    v_fma_f32 v122, v122, s48, -v156
    v_fma_f32 v123, v123, s48, -v156
    v_fma_f32 v124, v124, s48, -v156
    v_fma_f32 v125, v125, s48, -v156
    v_fma_f32 v126, v126, s48, -v156
    v_fma_f32 v127, v127, s48, -v156
    v_exp_f32 v120, v120
    v_exp_f32 v121, v121
    v_exp_f32 v122, v122
    v_exp_f32 v123, v123
    v_exp_f32 v124, v124
    v_exp_f32 v125, v125
    v_exp_f32 v126, v126
    v_exp_f32 v127, v127
    v_mul_f32 v152, v152, v155
    v_add_f32 v153, v120, v121
    v_add_f32 v154, v122, v123
    v_add_f32 v159, v124, v125
    v_add_f32 v153, v153, v154
    v_add_f32 v154, v126, v127
    v_add_f32 v159, v159, v154
    v_add_f32 v153, v153, v159
    v_add_f32 v152, v152, v153
    v_cvt_pk_bf16_f32 v128, v120, v121
    v_cvt_pk_bf16_f32 v129, v122, v123
    v_cvt_pk_bf16_f32 v130, v124, v125
    v_cvt_pk_bf16_f32 v131, v126, v127
    v_mul_f32 v24, v24, v155
    v_mul_f32 v25, v25, v155
    v_mul_f32 v26, v26, v155
    v_mul_f32 v27, v27, v155
    v_mul_f32 v28, v28, v155
    v_mul_f32 v29, v29, v155
    v_mul_f32 v30, v30, v155
    v_mul_f32 v31, v31, v155
    v_mul_f32 v32, v32, v155
    v_mul_f32 v33, v33, v155
    v_mul_f32 v34, v34, v155
    v_mul_f32 v35, v35, v155
    v_mul_f32 v36, v36, v155
    v_mul_f32 v37, v37, v155
    v_mul_f32 v38, v38, v155
    v_mul_f32 v39, v39, v155
    v_mul_f32 v40, v40, v155
    v_mul_f32 v41, v41, v155
    v_mul_f32 v42, v42, v155
    v_mul_f32 v43, v43, v155
    v_mul_f32 v44, v44, v155
    v_mul_f32 v45, v45, v155
    v_mul_f32 v46, v46, v155
    v_mul_f32 v47, v47, v155
    v_mul_f32 v48, v48, v155
    v_mul_f32 v49, v49, v155
    v_mul_f32 v50, v50, v155
    v_mul_f32 v51, v51, v155
    v_mul_f32 v52, v52, v155
    v_mul_f32 v53, v53, v155
    v_mul_f32 v54, v54, v155
    v_mul_f32 v55, v55, v155
    s_waitcnt lgkmcnt(0)
    v_mfma_f32_16x16x32_bf16 v[24:27], v[88:91], v[128:131], v[24:27]
    v_mfma_f32_16x16x32_bf16 v[28:31], v[92:95], v[128:131], v[28:31]
    v_mfma_f32_16x16x32_bf16 v[32:35], v[96:99], v[128:131], v[32:35]
    v_mfma_f32_16x16x32_bf16 v[36:39], v[100:103], v[128:131], v[36:39]
    v_mfma_f32_16x16x32_bf16 v[40:43], v[104:107], v[128:131], v[40:43]
    v_mfma_f32_16x16x32_bf16 v[44:47], v[108:111], v[128:131], v[44:47]
    v_mfma_f32_16x16x32_bf16 v[48:51], v[112:115], v[128:131], v[48:51]
    v_mfma_f32_16x16x32_bf16 v[52:55], v[116:119], v[128:131], v[52:55]
    s_cmp_ge_u32 s50, s41
    s_cbranch_scc1 K1_DONE
    s_waitcnt vmcnt(8)
    s_barrier
    v_readlane_b32 s51, v148, s49
    s_add_u32 m0, s52, 16384
    s_add_u32 s49, s49, 1
    s_nop 2
    buffer_load_dwordx4 v144, s[20:23], s51 offen offset:0 nt lds
    buffer_load_dwordx4 v145, s[20:23], s51 offen offset:1024 nt lds
    buffer_load_dwordx4 v146, s[20:23], s51 offen offset:2048 nt lds
    buffer_load_dwordx4 v147, s[20:23], s51 offen offset:3072 nt lds
    ds_read_b128 v[56:59], v132 offset:32768
    ds_read_b128 v[60:63], v133 offset:32768
    ds_read_b128 v[64:67], v134 offset:32768
    ds_read_b128 v[68:71], v135 offset:32768
    ds_read_b128 v[72:75], v132 offset:36864
    ds_read_b128 v[76:79], v133 offset:36864
    ds_read_b128 v[80:83], v134 offset:36864
    ds_read_b128 v[84:87], v135 offset:36864
    s_add_u32 s50, s50, 1
    s_cmp_eq_u32 s50, s41
    s_cselect_b32 s57, s47, 32
    s_waitcnt lgkmcnt(0)
    v_mfma_f32_16x16x32_bf16 v[120:123], v[56:59], v[8:11], 0
    v_mfma_f32_16x16x32_bf16 v[124:127], v[72:75], v[8:11], 0
    v_mfma_f32_16x16x32_bf16 v[120:123], v[60:63], v[12:15], v[120:123]
    v_mfma_f32_16x16x32_bf16 v[124:127], v[76:79], v[12:15], v[124:127]
    v_mfma_f32_16x16x32_bf16 v[120:123], v[64:67], v[16:19], v[120:123]
    v_mfma_f32_16x16x32_bf16 v[124:127], v[80:83], v[16:19], v[124:127]
    v_mfma_f32_16x16x32_bf16 v[120:123], v[68:71], v[20:23], v[120:123]
    v_mfma_f32_16x16x32_bf16 v[124:127], v[84:87], v[20:23], v[124:127]
    ds_read_b64_tr_b16 v[88:89], v136 offset:40960
    ds_read_b64_tr_b16 v[90:91], v136 offset:45056
    ds_read_b64_tr_b16 v[92:93], v137 offset:40960
    ds_read_b64_tr_b16 v[94:95], v137 offset:45056
    ds_read_b64_tr_b16 v[96:97], v138 offset:40960
    ds_read_b64_tr_b16 v[98:99], v138 offset:45056
    ds_read_b64_tr_b16 v[100:101], v139 offset:40960
    ds_read_b64_tr_b16 v[102:103], v139 offset:45056
    ds_read_b64_tr_b16 v[104:105], v140 offset:40960
    ds_read_b64_tr_b16 v[106:107], v140 offset:45056
    ds_read_b64_tr_b16 v[108:109], v141 offset:40960
    ds_read_b64_tr_b16 v[110:111], v141 offset:45056
    ds_read_b64_tr_b16 v[112:113], v142 offset:40960
    ds_read_b64_tr_b16 v[114:115], v142 offset:45056
    ds_read_b64_tr_b16 v[116:117], v143 offset:40960
    ds_read_b64_tr_b16 v[118:119], v143 offset:45056
    s_cmp_lt_u32 s57, 32
    s_nop 7
    s_cbranch_scc0 K1_NOMASK_2
    s_sub_u32 s53, s57, 0
    v_mov_b32 v153, 0xff800000
    v_cmp_gt_i32 vcc, s53, v149
    s_nop 1
    v_cndmask_b32 v120, v153, v120, vcc
    s_sub_u32 s53, s57, 1
    v_mov_b32 v153, 0xff800000
    v_cmp_gt_i32 vcc, s53, v149
    s_nop 1
    v_cndmask_b32 v121, v153, v121, vcc
    s_sub_u32 s53, s57, 2
    v_mov_b32 v153, 0xff800000
    v_cmp_gt_i32 vcc, s53, v149
    s_nop 1
    v_cndmask_b32 v122, v153, v122, vcc
    s_sub_u32 s53, s57, 3
    v_mov_b32 v153, 0xff800000
    v_cmp_gt_i32 vcc, s53, v149
    s_nop 1
    v_cndmask_b32 v123, v153, v123, vcc
    s_sub_u32 s53, s57, 16
    v_mov_b32 v153, 0xff800000
    v_cmp_gt_i32 vcc, s53, v149
    s_nop 1
    v_cndmask_b32 v124, v153, v124, vcc
    s_sub_u32 s53, s57, 17
    v_mov_b32 v153, 0xff800000
    v_cmp_gt_i32 vcc, s53, v149
    s_nop 1
    v_cndmask_b32 v125, v153, v125, vcc
    s_sub_u32 s53, s57, 18
    v_mov_b32 v153, 0xff800000
    v_cmp_gt_i32 vcc, s53, v149
    s_nop 1
    v_cndmask_b32 v126, v153, v126, vcc
    s_sub_u32 s53, s57, 19
    v_mov_b32 v153, 0xff800000
    v_cmp_gt_i32 vcc, s53, v149
    s_nop 1
    v_cndmask_b32 v127, v153, v127, vcc
K1_NOMASK_2:
    v_max3_f32 v153, v120, v121, v122
    v_max3_f32 v154, v123, v124, v125
    v_max3_f32 v153, v153, v126, v127
    v_max3_f32 v153, v153, v154, v150
    v_mov_b32 v154, v153
    s_nop 1
    v_permlane16_swap_b32 v153, v154
    v_max_f32 v153, v153, v154
    v_mov_b32 v154, v153
    s_nop 1
    v_permlane32_swap_b32 v153, v154
    v_max_f32 v150, v153, v154
    v_mul_f32 v156, s48, v150
    v_sub_f32 v153, v151, v156
    v_exp_f32 v155, v153
    v_mov_b32 v151, v156
    v_fma_f32 v120, v120, s48, -v156
    v_fma_f32 v121, v121, s48, -v156
    v_fma_f32 v122, v122, s48, -v156
    v_fma_f32 v123, v123, s48, -v156
    v_fma_f32 v124, v124, s48, -v156
    v_fma_f32 v125, v125, s48, -v156
    v_fma_f32 v126, v126, s48, -v156
    v_fma_f32 v127, v127, s48, -v156
    v_exp_f32 v120, v120
    v_exp_f32 v121, v121
    v_exp_f32 v122, v122
    v_exp_f32 v123, v123
    v_exp_f32 v124, v124
    v_exp_f32 v125, v125
    v_exp_f32 v126, v126
    v_exp_f32 v127, v127
    v_mul_f32 v152, v152, v155
    v_add_f32 v153, v120, v121
    v_add_f32 v154, v122, v123
    v_add_f32 v159, v124, v125
    v_add_f32 v153, v153, v154
    v_add_f32 v154, v126, v127
    v_add_f32 v159, v159, v154
    v_add_f32 v153, v153, v159
    v_add_f32 v152, v152, v153
    v_cvt_pk_bf16_f32 v128, v120, v121
    v_cvt_pk_bf16_f32 v129, v122, v123
    v_cvt_pk_bf16_f32 v130, v124, v125
    v_cvt_pk_bf16_f32 v131, v126, v127
    v_mul_f32 v24, v24, v155
    v_mul_f32 v25, v25, v155
    v_mul_f32 v26, v26, v155
    v_mul_f32 v27, v27, v155
    v_mul_f32 v28, v28, v155
    v_mul_f32 v29, v29, v155
    v_mul_f32 v30, v30, v155
    v_mul_f32 v31, v31, v155
    v_mul_f32 v32, v32, v155
    v_mul_f32 v33, v33, v155
    v_mul_f32 v34, v34, v155
    v_mul_f32 v35, v35, v155
    v_mul_f32 v36, v36, v155
    v_mul_f32 v37, v37, v155
    v_mul_f32 v38, v38, v155
    v_mul_f32 v39, v39, v155
    v_mul_f32 v40, v40, v155
    v_mul_f32 v41, v41, v155
    v_mul_f32 v42, v42, v155
    v_mul_f32 v43, v43, v155
    v_mul_f32 v44, v44, v155
    v_mul_f32 v45, v45, v155
    v_mul_f32 v46, v46, v155
    v_mul_f32 v47, v47, v155
    v_mul_f32 v48, v48, v155
    v_mul_f32 v49, v49, v155
    v_mul_f32 v50, v50, v155
    v_mul_f32 v51, v51, v155
    v_mul_f32 v52, v52, v155
    v_mul_f32 v53, v53, v155
    v_mul_f32 v54, v54, v155
    v_mul_f32 v55, v55, v155
    s_waitcnt lgkmcnt(0)
    v_mfma_f32_16x16x32_bf16 v[24:27], v[88:91], v[128:131], v[24:27]
    v_mfma_f32_16x16x32_bf16 v[28:31], v[92:95], v[128:131], v[28:31]
    v_mfma_f32_16x16x32_bf16 v[32:35], v[96:99], v[128:131], v[32:35]
    v_mfma_f32_16x16x32_bf16 v[36:39], v[100:103], v[128:131], v[36:39]
    v_mfma_f32_16x16x32_bf16 v[40:43], v[104:107], v[128:131], v[40:43]
    v_mfma_f32_16x16x32_bf16 v[44:47], v[108:111], v[128:131], v[44:47]
    v_mfma_f32_16x16x32_bf16 v[48:51], v[112:115], v[128:131], v[48:51]
    v_mfma_f32_16x16x32_bf16 v[52:55], v[116:119], v[128:131], v[52:55]
    s_cmp_ge_u32 s50, s41
    s_cbranch_scc1 K1_DONE
    s_waitcnt vmcnt(8)
    s_barrier
    v_readlane_b32 s51, v148, s49
    s_add_u32 m0, s52, 32768
    s_add_u32 s49, s49, 1
    s_nop 2
    buffer_load_dwordx4 v144, s[20:23], s51 offen offset:0 nt lds
    buffer_load_dwordx4 v145, s[20:23], s51 offen offset:1024 nt lds
    buffer_load_dwordx4 v146, s[20:23], s51 offen offset:2048 nt lds
    buffer_load_dwordx4 v147, s[20:23], s51 offen offset:3072 nt lds
    ds_read_b128 v[56:59], v132 offset:49152
    ds_read_b128 v[60:63], v133 offset:49152
    ds_read_b128 v[64:67], v134 offset:49152
    ds_read_b128 v[68:71], v135 offset:49152
    ds_read_b128 v[72:75], v132 offset:53248
    ds_read_b128 v[76:79], v133 offset:53248
    ds_read_b128 v[80:83], v134 offset:53248
    ds_read_b128 v[84:87], v135 offset:53248
    s_add_u32 s50, s50, 1
    s_cmp_eq_u32 s50, s41
    s_cselect_b32 s57, s47, 32
    s_waitcnt lgkmcnt(0)
    v_mfma_f32_16x16x32_bf16 v[120:123], v[56:59], v[8:11], 0
    v_mfma_f32_16x16x32_bf16 v[124:127], v[72:75], v[8:11], 0
    v_mfma_f32_16x16x32_bf16 v[120:123], v[60:63], v[12:15], v[120:123]
    v_mfma_f32_16x16x32_bf16 v[124:127], v[76:79], v[12:15], v[124:127]
    v_mfma_f32_16x16x32_bf16 v[120:123], v[64:67], v[16:19], v[120:123]
    v_mfma_f32_16x16x32_bf16 v[124:127], v[80:83], v[16:19], v[124:127]
    v_mfma_f32_16x16x32_bf16 v[120:123], v[68:71], v[20:23], v[120:123]
    v_mfma_f32_16x16x32_bf16 v[124:127], v[84:87], v[20:23], v[124:127]
    ds_read_b64_tr_b16 v[88:89], v136 offset:57344
    ds_read_b64_tr_b16 v[90:91], v136 offset:61440
    ds_read_b64_tr_b16 v[92:93], v137 offset:57344
    ds_read_b64_tr_b16 v[94:95], v137 offset:61440
    ds_read_b64_tr_b16 v[96:97], v138 offset:57344
    ds_read_b64_tr_b16 v[98:99], v138 offset:61440
    ds_read_b64_tr_b16 v[100:101], v139 offset:57344
    ds_read_b64_tr_b16 v[102:103], v139 offset:61440
    ds_read_b64_tr_b16 v[104:105], v140 offset:57344
    ds_read_b64_tr_b16 v[106:107], v140 offset:61440
    ds_read_b64_tr_b16 v[108:109], v141 offset:57344
    ds_read_b64_tr_b16 v[110:111], v141 offset:61440
    ds_read_b64_tr_b16 v[112:113], v142 offset:57344
    ds_read_b64_tr_b16 v[114:115], v142 offset:61440
    ds_read_b64_tr_b16 v[116:117], v143 offset:57344
    ds_read_b64_tr_b16 v[118:119], v143 offset:61440
    s_cmp_lt_u32 s57, 32
    s_nop 7
    s_cbranch_scc0 K1_NOMASK_3
    s_sub_u32 s53, s57, 0
    v_mov_b32 v153, 0xff800000
    v_cmp_gt_i32 vcc, s53, v149
    s_nop 1
    v_cndmask_b32 v120, v153, v120, vcc
    s_sub_u32 s53, s57, 1
    v_mov_b32 v153, 0xff800000
    v_cmp_gt_i32 vcc, s53, v149
    s_nop 1
    v_cndmask_b32 v121, v153, v121, vcc
    s_sub_u32 s53, s57, 2
    v_mov_b32 v153, 0xff800000
    v_cmp_gt_i32 vcc, s53, v149
    s_nop 1
    v_cndmask_b32 v122, v153, v122, vcc
    s_sub_u32 s53, s57, 3
    v_mov_b32 v153, 0xff800000
    v_cmp_gt_i32 vcc, s53, v149
    s_nop 1
    v_cndmask_b32 v123, v153, v123, vcc
    s_sub_u32 s53, s57, 16
    v_mov_b32 v153, 0xff800000
    v_cmp_gt_i32 vcc, s53, v149
    s_nop 1
    v_cndmask_b32 v124, v153, v124, vcc
    s_sub_u32 s53, s57, 17
    v_mov_b32 v153, 0xff800000
    v_cmp_gt_i32 vcc, s53, v149
    s_nop 1
    v_cndmask_b32 v125, v153, v125, vcc
    s_sub_u32 s53, s57, 18
    v_mov_b32 v153, 0xff800000
    v_cmp_gt_i32 vcc, s53, v149
    s_nop 1
    v_cndmask_b32 v126, v153, v126, vcc
    s_sub_u32 s53, s57, 19
    v_mov_b32 v153, 0xff800000
    v_cmp_gt_i32 vcc, s53, v149
    s_nop 1
    v_cndmask_b32 v127, v153, v127, vcc
K1_NOMASK_3:
    v_max3_f32 v153, v120, v121, v122
    v_max3_f32 v154, v123, v124, v125
    v_max3_f32 v153, v153, v126, v127
    v_max3_f32 v153, v153, v154, v150
    v_mov_b32 v154, v153
    s_nop 1
    v_permlane16_swap_b32 v153, v154
    v_max_f32 v153, v153, v154
    v_mov_b32 v154, v153
    s_nop 1
    v_permlane32_swap_b32 v153, v154
    v_max_f32 v150, v153, v154
    v_mul_f32 v156, s48, v150
    v_sub_f32 v153, v151, v156
    v_exp_f32 v155, v153
    v_mov_b32 v151, v156
    v_fma_f32 v120, v120, s48, -v156
    v_fma_f32 v121, v121, s48, -v156
    v_fma_f32 v122, v122, s48, -v156
    v_fma_f32 v123, v123, s48, -v156
    v_fma_f32 v124, v124, s48, -v156
    v_fma_f32 v125, v125, s48, -v156
    v_fma_f32 v126, v126, s48, -v156
    v_fma_f32 v127, v127, s48, -v156
    v_exp_f32 v120, v120
    v_exp_f32 v121, v121
    v_exp_f32 v122, v122
    v_exp_f32 v123, v123
    v_exp_f32 v124, v124
    v_exp_f32 v125, v125
    v_exp_f32 v126, v126
    v_exp_f32 v127, v127
    v_mul_f32 v152, v152, v155
    v_add_f32 v153, v120, v121
    v_add_f32 v154, v122, v123
    v_add_f32 v159, v124, v125
    v_add_f32 v153, v153, v154
    v_add_f32 v154, v126, v127
    v_add_f32 v159, v159, v154
    v_add_f32 v153, v153, v159
    v_add_f32 v152, v152, v153
    v_cvt_pk_bf16_f32 v128, v120, v121
    v_cvt_pk_bf16_f32 v129, v122, v123
    v_cvt_pk_bf16_f32 v130, v124, v125
    v_cvt_pk_bf16_f32 v131, v126, v127
    v_mul_f32 v24, v24, v155
    v_mul_f32 v25, v25, v155
    v_mul_f32 v26, v26, v155
    v_mul_f32 v27, v27, v155
    v_mul_f32 v28, v28, v155
    v_mul_f32 v29, v29, v155
    v_mul_f32 v30, v30, v155
    v_mul_f32 v31, v31, v155
    v_mul_f32 v32, v32, v155
    v_mul_f32 v33, v33, v155
    v_mul_f32 v34, v34, v155
    v_mul_f32 v35, v35, v155
    v_mul_f32 v36, v36, v155
    v_mul_f32 v37, v37, v155
    v_mul_f32 v38, v38, v155
    v_mul_f32 v39, v39, v155
    v_mul_f32 v40, v40, v155
    v_mul_f32 v41, v41, v155
    v_mul_f32 v42, v42, v155
    v_mul_f32 v43, v43, v155
    v_mul_f32 v44, v44, v155
    v_mul_f32 v45, v45, v155
    v_mul_f32 v46, v46, v155
    v_mul_f32 v47, v47, v155
    v_mul_f32 v48, v48, v155
    v_mul_f32 v49, v49, v155
    v_mul_f32 v50, v50, v155
    v_mul_f32 v51, v51, v155
    v_mul_f32 v52, v52, v155
    v_mul_f32 v53, v53, v155
    v_mul_f32 v54, v54, v155
    v_mul_f32 v55, v55, v155
    s_waitcnt lgkmcnt(0)
    v_mfma_f32_16x16x32_bf16 v[24:27], v[88:91], v[128:131], v[24:27]
    v_mfma_f32_16x16x32_bf16 v[28:31], v[92:95], v[128:131], v[28:31]
    v_mfma_f32_16x16x32_bf16 v[32:35], v[96:99], v[128:131], v[32:35]
    v_mfma_f32_16x16x32_bf16 v[36:39], v[100:103], v[128:131], v[36:39]
    v_mfma_f32_16x16x32_bf16 v[40:43], v[104:107], v[128:131], v[40:43]
    v_mfma_f32_16x16x32_bf16 v[44:47], v[108:111], v[128:131], v[44:47]
    v_mfma_f32_16x16x32_bf16 v[48:51], v[112:115], v[128:131], v[48:51]
    v_mfma_f32_16x16x32_bf16 v[52:55], v[116:119], v[128:131], v[52:55]
    s_cmp_ge_u32 s50, s41
    s_cbranch_scc1 K1_DONE
    s_branch K1_LOOP
K1_DONE:
    v_mov_b32 v154, v152
    s_nop 1
    v_permlane16_swap_b32 v152, v154
    v_add_f32 v152, v152, v154
    v_mov_b32 v154, v152
    s_nop 1
    v_permlane32_swap_b32 v152, v154
    v_add_f32 v152, v152, v154
    v_and_b32 v154, 15, v157
    v_lshrrev_b32 v153, 4, v157
    s_lshl_b32 s53, s36, 4
    v_add_u32 v154, s53, v154
    v_lshlrev_b32 v153, 4, v153
    v_lshl_add_u32 v158, v154, 9, v153
    v_lshlrev_b32 v154, 3, v154
    s_lshl_b32 s53, s2, 15
    s_lshl_b32 s54, s2, 9
    s_add_u32 s54, s54, 16777216
    s_nop 4
    buffer_store_dwordx4 v[24:27], v158, s[32:35], s53 offen offset:0
    buffer_store_dwordx4 v[28:31], v158, s[32:35], s53 offen offset:64
    buffer_store_dwordx4 v[32:35], v158, s[32:35], s53 offen offset:128
    buffer_store_dwordx4 v[36:39], v158, s[32:35], s53 offen offset:192
    buffer_store_dwordx4 v[40:43], v158, s[32:35], s53 offen offset:256
    buffer_store_dwordx4 v[44:47], v158, s[32:35], s53 offen offset:320
    buffer_store_dwordx4 v[48:51], v158, s[32:35], s53 offen offset:384
    buffer_store_dwordx4 v[52:55], v158, s[32:35], s53 offen offset:448
    v_mov_b32 v120, v151
    v_mov_b32 v121, v152
    buffer_store_dwordx2 v[120:121], v154, s[32:35], s54 offen
K1_EXIT:
    s_waitcnt vmcnt(0)
    s_endpgm
.globl standalone__paged_block_table_kv_pagedattention__sampling_combine_kernel
.p2align 8
.type standalone__paged_block_table_kv_pagedattention__sampling_combine_kernel,@function
standalone__paged_block_table_kv_pagedattention__sampling_combine_kernel:
    s_load_dwordx16 s[4:19], s[0:1], 0
    s_cmp_ge_u32 s2, 256
    s_cbranch_scc1 K2_EXIT
    v_and_b32 v105, 63, v0
    v_and_b32 v102, 15, v0
    v_lshlrev_b32 v101, 2, v102
    s_waitcnt lgkmcnt(0)
    s_mov_b32 s24, s12
    s_and_b32 s25, s13, 0xffff
    s_mov_b32 s26, 64
    s_mov_b32 s27, 0x20000
    buffer_load_dword v106, v101, s[24:27], 0 offen
    s_mov_b32 s32, s18
    s_and_b32 s33, s19, 0xffff
    s_mov_b32 s34, 268697600
    s_mov_b32 s35, 0x20000
    s_mov_b32 s28, s14
    s_and_b32 s29, s15, 0xffff
    s_mov_b32 s30, 1048576
    s_mov_b32 s31, 0x20000
    s_lshr_b32 s38, s2, 2
    s_lshr_b32 s36, s38, 2
    s_and_b32 s37, s38, 3
    s_and_b32 s45, s2, 3
    s_lshl_b32 s45, s45, 4
    v_lshrrev_b32 v101, 4, v0
    v_add_u32 v101, s45, v101
    v_lshlrev_b32 v102, 5, v102
    v_lshl_add_u32 v103, v101, 9, v102
    v_lshlrev_b32 v104, 3, v101
    s_waitcnt vmcnt(0)
    v_mov_b32 v107, 0x1000
    v_min_i32 v112, v106, v107
    v_cmp_lt_i32 vcc, 0, v106
    s_nop 1
    v_cndmask_b32 v107, v107, v112, vcc
    v_add_u32 v108, 31, v107
    v_lshrrev_b32 v108, 5, v108
    v_mov_b32 v111, v108
    s_nop 1
    v_add_u32_dpp v111, v111, v111 row_shr:1 row_mask:0xf bank_mask:0xf bound_ctrl:0
    s_nop 1
    v_add_u32_dpp v111, v111, v111 row_shr:2 row_mask:0xf bank_mask:0xf bound_ctrl:0
    s_nop 1
    v_add_u32_dpp v111, v111, v111 row_shr:4 row_mask:0xf bank_mask:0xf bound_ctrl:0
    s_nop 1
    v_add_u32_dpp v111, v111, v111 row_shr:8 row_mask:0xf bank_mask:0xf bound_ctrl:0
    s_nop 1
    v_readlane_b32 s42, v111, 15
    s_nop 3
    s_lshl_b32 s42, s42, 2
    s_add_u32 s45, s42, 447
    s_mov_b32 s43, 9586981
    s_mul_hi_u32 s43, s45, s43
    v_cvt_f32_u32 v113, s43
    v_rcp_f32 v113, v113
    v_add_u32 v112, s43, v108
    v_cvt_f32_u32 v112, v112
    v_add_f32 v112, -0.5, v112
    v_mul_f32 v112, v112, v113
    v_cvt_u32_f32 v109, v112
    v_lshlrev_b32 v111, 2, v109
    s_nop 1
    v_add_u32_dpp v111, v111, v111 row_shr:1 row_mask:0xf bank_mask:0xf bound_ctrl:0
    s_nop 1
    v_add_u32_dpp v111, v111, v111 row_shr:2 row_mask:0xf bank_mask:0xf bound_ctrl:0
    s_nop 1
    v_add_u32_dpp v111, v111, v111 row_shr:4 row_mask:0xf bank_mask:0xf bound_ctrl:0
    s_nop 1
    v_add_u32_dpp v111, v111, v111 row_shr:8 row_mask:0xf bank_mask:0xf bound_ctrl:0
    v_lshlrev_b32 v112, 2, v109
    v_sub_u32 v110, v111, v112
    s_nop 0
    v_readlane_b32 s44, v111, 15
    s_nop 3
    v_readlane_b32 s39, v109, s36
    v_readlane_b32 s40, v110, s36
    v_mov_b32 v8, 0
    v_mov_b32 v9, 0
    v_mov_b32 v10, 0
    v_mov_b32 v11, 0
    v_mov_b32 v12, 0
    v_mov_b32 v13, 0
    v_mov_b32 v14, 0
    v_mov_b32 v15, 0
    v_mov_b32 v96, 0xff800000
    v_mov_b32 v97, 0
    s_mov_b32 s41, 0
    s_mov_b32 s72, 0x7f800000
    s_mov_b32 s73, 0xff800000
K2_BATCH:
    s_add_u32 s45, s41, 0
    s_cmp_lt_u32 s45, s39
    s_cselect_b32 s64, s72, s73
    s_sub_u32 s46, s39, 1
    s_min_u32 s45, s45, s46
    s_lshl_b32 s45, s45, 2
    s_add_u32 s45, s45, s40
    s_add_u32 s45, s45, s37
    s_lshl_b32 s48, s45, 15
    s_lshl_b32 s56, s45, 9
    s_add_u32 s56, s56, 16777216
    buffer_load_dwordx2 v[80:81], v104, s[32:35], s56 offen
    buffer_load_dwordx4 v[16:19], v103, s[32:35], s48 offen
    buffer_load_dwordx4 v[20:23], v103, s[32:35], s48 offen offset:16
    s_add_u32 s45, s41, 1
    s_cmp_lt_u32 s45, s39
    s_cselect_b32 s65, s72, s73
    s_sub_u32 s46, s39, 1
    s_min_u32 s45, s45, s46
    s_lshl_b32 s45, s45, 2
    s_add_u32 s45, s45, s40
    s_add_u32 s45, s45, s37
    s_lshl_b32 s49, s45, 15
    s_lshl_b32 s57, s45, 9
    s_add_u32 s57, s57, 16777216
    buffer_load_dwordx2 v[82:83], v104, s[32:35], s57 offen
    buffer_load_dwordx4 v[24:27], v103, s[32:35], s49 offen
    buffer_load_dwordx4 v[28:31], v103, s[32:35], s49 offen offset:16
    s_add_u32 s45, s41, 2
    s_cmp_lt_u32 s45, s39
    s_cselect_b32 s66, s72, s73
    s_sub_u32 s46, s39, 1
    s_min_u32 s45, s45, s46
    s_lshl_b32 s45, s45, 2
    s_add_u32 s45, s45, s40
    s_add_u32 s45, s45, s37
    s_lshl_b32 s50, s45, 15
    s_lshl_b32 s58, s45, 9
    s_add_u32 s58, s58, 16777216
    buffer_load_dwordx2 v[84:85], v104, s[32:35], s58 offen
    buffer_load_dwordx4 v[32:35], v103, s[32:35], s50 offen
    buffer_load_dwordx4 v[36:39], v103, s[32:35], s50 offen offset:16
    s_add_u32 s45, s41, 3
    s_cmp_lt_u32 s45, s39
    s_cselect_b32 s67, s72, s73
    s_sub_u32 s46, s39, 1
    s_min_u32 s45, s45, s46
    s_lshl_b32 s45, s45, 2
    s_add_u32 s45, s45, s40
    s_add_u32 s45, s45, s37
    s_lshl_b32 s51, s45, 15
    s_lshl_b32 s59, s45, 9
    s_add_u32 s59, s59, 16777216
    buffer_load_dwordx2 v[86:87], v104, s[32:35], s59 offen
    buffer_load_dwordx4 v[40:43], v103, s[32:35], s51 offen
    buffer_load_dwordx4 v[44:47], v103, s[32:35], s51 offen offset:16
    s_add_u32 s45, s41, 4
    s_cmp_lt_u32 s45, s39
    s_cselect_b32 s68, s72, s73
    s_sub_u32 s46, s39, 1
    s_min_u32 s45, s45, s46
    s_lshl_b32 s45, s45, 2
    s_add_u32 s45, s45, s40
    s_add_u32 s45, s45, s37
    s_lshl_b32 s52, s45, 15
    s_lshl_b32 s60, s45, 9
    s_add_u32 s60, s60, 16777216
    buffer_load_dwordx2 v[88:89], v104, s[32:35], s60 offen
    buffer_load_dwordx4 v[48:51], v103, s[32:35], s52 offen
    buffer_load_dwordx4 v[52:55], v103, s[32:35], s52 offen offset:16
    s_add_u32 s45, s41, 5
    s_cmp_lt_u32 s45, s39
    s_cselect_b32 s69, s72, s73
    s_sub_u32 s46, s39, 1
    s_min_u32 s45, s45, s46
    s_lshl_b32 s45, s45, 2
    s_add_u32 s45, s45, s40
    s_add_u32 s45, s45, s37
    s_lshl_b32 s53, s45, 15
    s_lshl_b32 s61, s45, 9
    s_add_u32 s61, s61, 16777216
    buffer_load_dwordx2 v[90:91], v104, s[32:35], s61 offen
    buffer_load_dwordx4 v[56:59], v103, s[32:35], s53 offen
    buffer_load_dwordx4 v[60:63], v103, s[32:35], s53 offen offset:16
    s_add_u32 s45, s41, 6
    s_cmp_lt_u32 s45, s39
    s_cselect_b32 s70, s72, s73
    s_sub_u32 s46, s39, 1
    s_min_u32 s45, s45, s46
    s_lshl_b32 s45, s45, 2
    s_add_u32 s45, s45, s40
    s_add_u32 s45, s45, s37
    s_lshl_b32 s54, s45, 15
    s_lshl_b32 s62, s45, 9
    s_add_u32 s62, s62, 16777216
    buffer_load_dwordx2 v[92:93], v104, s[32:35], s62 offen
    buffer_load_dwordx4 v[64:67], v103, s[32:35], s54 offen
    buffer_load_dwordx4 v[68:71], v103, s[32:35], s54 offen offset:16
    s_add_u32 s45, s41, 7
    s_cmp_lt_u32 s45, s39
    s_cselect_b32 s71, s72, s73
    s_sub_u32 s46, s39, 1
    s_min_u32 s45, s45, s46
    s_lshl_b32 s45, s45, 2
    s_add_u32 s45, s45, s40
    s_add_u32 s45, s45, s37
    s_lshl_b32 s55, s45, 15
    s_lshl_b32 s63, s45, 9
    s_add_u32 s63, s63, 16777216
    buffer_load_dwordx2 v[94:95], v104, s[32:35], s63 offen
    buffer_load_dwordx4 v[72:75], v103, s[32:35], s55 offen
    buffer_load_dwordx4 v[76:79], v103, s[32:35], s55 offen offset:16
    s_waitcnt vmcnt(21)
    v_min_f32 v101, s64, v80
    v_max_f32 v98, v96, v101
    v_sub_f32 v99, v96, v98
    v_sub_f32 v100, v101, v98
    v_exp_f32 v99, v99
    v_exp_f32 v100, v100
    v_mov_b32 v96, v98
    v_mul_f32 v97, v97, v99
    v_fma_f32 v97, v81, v100, v97
    v_mul_f32 v8, v8, v99
    v_fma_f32 v8, v16, v100, v8
    v_mul_f32 v9, v9, v99
    v_fma_f32 v9, v17, v100, v9
    v_mul_f32 v10, v10, v99
    v_fma_f32 v10, v18, v100, v10
    v_mul_f32 v11, v11, v99
    v_fma_f32 v11, v19, v100, v11
    v_mul_f32 v12, v12, v99
    v_fma_f32 v12, v20, v100, v12
    v_mul_f32 v13, v13, v99
    v_fma_f32 v13, v21, v100, v13
    v_mul_f32 v14, v14, v99
    v_fma_f32 v14, v22, v100, v14
    v_mul_f32 v15, v15, v99
    v_fma_f32 v15, v23, v100, v15
    s_waitcnt vmcnt(18)
    v_min_f32 v101, s65, v82
    v_max_f32 v98, v96, v101
    v_sub_f32 v99, v96, v98
    v_sub_f32 v100, v101, v98
    v_exp_f32 v99, v99
    v_exp_f32 v100, v100
    v_mov_b32 v96, v98
    v_mul_f32 v97, v97, v99
    v_fma_f32 v97, v83, v100, v97
    v_mul_f32 v8, v8, v99
    v_fma_f32 v8, v24, v100, v8
    v_mul_f32 v9, v9, v99
    v_fma_f32 v9, v25, v100, v9
    v_mul_f32 v10, v10, v99
    v_fma_f32 v10, v26, v100, v10
    v_mul_f32 v11, v11, v99
    v_fma_f32 v11, v27, v100, v11
    v_mul_f32 v12, v12, v99
    v_fma_f32 v12, v28, v100, v12
    v_mul_f32 v13, v13, v99
    v_fma_f32 v13, v29, v100, v13
    v_mul_f32 v14, v14, v99
    v_fma_f32 v14, v30, v100, v14
    v_mul_f32 v15, v15, v99
    v_fma_f32 v15, v31, v100, v15
    s_waitcnt vmcnt(15)
    v_min_f32 v101, s66, v84
    v_max_f32 v98, v96, v101
    v_sub_f32 v99, v96, v98
    v_sub_f32 v100, v101, v98
    v_exp_f32 v99, v99
    v_exp_f32 v100, v100
    v_mov_b32 v96, v98
    v_mul_f32 v97, v97, v99
    v_fma_f32 v97, v85, v100, v97
    v_mul_f32 v8, v8, v99
    v_fma_f32 v8, v32, v100, v8
    v_mul_f32 v9, v9, v99
    v_fma_f32 v9, v33, v100, v9
    v_mul_f32 v10, v10, v99
    v_fma_f32 v10, v34, v100, v10
    v_mul_f32 v11, v11, v99
    v_fma_f32 v11, v35, v100, v11
    v_mul_f32 v12, v12, v99
    v_fma_f32 v12, v36, v100, v12
    v_mul_f32 v13, v13, v99
    v_fma_f32 v13, v37, v100, v13
    v_mul_f32 v14, v14, v99
    v_fma_f32 v14, v38, v100, v14
    v_mul_f32 v15, v15, v99
    v_fma_f32 v15, v39, v100, v15
    s_waitcnt vmcnt(12)
    v_min_f32 v101, s67, v86
    v_max_f32 v98, v96, v101
    v_sub_f32 v99, v96, v98
    v_sub_f32 v100, v101, v98
    v_exp_f32 v99, v99
    v_exp_f32 v100, v100
    v_mov_b32 v96, v98
    v_mul_f32 v97, v97, v99
    v_fma_f32 v97, v87, v100, v97
    v_mul_f32 v8, v8, v99
    v_fma_f32 v8, v40, v100, v8
    v_mul_f32 v9, v9, v99
    v_fma_f32 v9, v41, v100, v9
    v_mul_f32 v10, v10, v99
    v_fma_f32 v10, v42, v100, v10
    v_mul_f32 v11, v11, v99
    v_fma_f32 v11, v43, v100, v11
    v_mul_f32 v12, v12, v99
    v_fma_f32 v12, v44, v100, v12
    v_mul_f32 v13, v13, v99
    v_fma_f32 v13, v45, v100, v13
    v_mul_f32 v14, v14, v99
    v_fma_f32 v14, v46, v100, v14
    v_mul_f32 v15, v15, v99
    v_fma_f32 v15, v47, v100, v15
    s_waitcnt vmcnt(9)
    v_min_f32 v101, s68, v88
    v_max_f32 v98, v96, v101
    v_sub_f32 v99, v96, v98
    v_sub_f32 v100, v101, v98
    v_exp_f32 v99, v99
    v_exp_f32 v100, v100
    v_mov_b32 v96, v98
    v_mul_f32 v97, v97, v99
    v_fma_f32 v97, v89, v100, v97
    v_mul_f32 v8, v8, v99
    v_fma_f32 v8, v48, v100, v8
    v_mul_f32 v9, v9, v99
    v_fma_f32 v9, v49, v100, v9
    v_mul_f32 v10, v10, v99
    v_fma_f32 v10, v50, v100, v10
    v_mul_f32 v11, v11, v99
    v_fma_f32 v11, v51, v100, v11
    v_mul_f32 v12, v12, v99
    v_fma_f32 v12, v52, v100, v12
    v_mul_f32 v13, v13, v99
    v_fma_f32 v13, v53, v100, v13
    v_mul_f32 v14, v14, v99
    v_fma_f32 v14, v54, v100, v14
    v_mul_f32 v15, v15, v99
    v_fma_f32 v15, v55, v100, v15
    s_waitcnt vmcnt(6)
    v_min_f32 v101, s69, v90
    v_max_f32 v98, v96, v101
    v_sub_f32 v99, v96, v98
    v_sub_f32 v100, v101, v98
    v_exp_f32 v99, v99
    v_exp_f32 v100, v100
    v_mov_b32 v96, v98
    v_mul_f32 v97, v97, v99
    v_fma_f32 v97, v91, v100, v97
    v_mul_f32 v8, v8, v99
    v_fma_f32 v8, v56, v100, v8
    v_mul_f32 v9, v9, v99
    v_fma_f32 v9, v57, v100, v9
    v_mul_f32 v10, v10, v99
    v_fma_f32 v10, v58, v100, v10
    v_mul_f32 v11, v11, v99
    v_fma_f32 v11, v59, v100, v11
    v_mul_f32 v12, v12, v99
    v_fma_f32 v12, v60, v100, v12
    v_mul_f32 v13, v13, v99
    v_fma_f32 v13, v61, v100, v13
    v_mul_f32 v14, v14, v99
    v_fma_f32 v14, v62, v100, v14
    v_mul_f32 v15, v15, v99
    v_fma_f32 v15, v63, v100, v15
    s_waitcnt vmcnt(3)
    v_min_f32 v101, s70, v92
    v_max_f32 v98, v96, v101
    v_sub_f32 v99, v96, v98
    v_sub_f32 v100, v101, v98
    v_exp_f32 v99, v99
    v_exp_f32 v100, v100
    v_mov_b32 v96, v98
    v_mul_f32 v97, v97, v99
    v_fma_f32 v97, v93, v100, v97
    v_mul_f32 v8, v8, v99
    v_fma_f32 v8, v64, v100, v8
    v_mul_f32 v9, v9, v99
    v_fma_f32 v9, v65, v100, v9
    v_mul_f32 v10, v10, v99
    v_fma_f32 v10, v66, v100, v10
    v_mul_f32 v11, v11, v99
    v_fma_f32 v11, v67, v100, v11
    v_mul_f32 v12, v12, v99
    v_fma_f32 v12, v68, v100, v12
    v_mul_f32 v13, v13, v99
    v_fma_f32 v13, v69, v100, v13
    v_mul_f32 v14, v14, v99
    v_fma_f32 v14, v70, v100, v14
    v_mul_f32 v15, v15, v99
    v_fma_f32 v15, v71, v100, v15
    s_waitcnt vmcnt(0)
    v_min_f32 v101, s71, v94
    v_max_f32 v98, v96, v101
    v_sub_f32 v99, v96, v98
    v_sub_f32 v100, v101, v98
    v_exp_f32 v99, v99
    v_exp_f32 v100, v100
    v_mov_b32 v96, v98
    v_mul_f32 v97, v97, v99
    v_fma_f32 v97, v95, v100, v97
    v_mul_f32 v8, v8, v99
    v_fma_f32 v8, v72, v100, v8
    v_mul_f32 v9, v9, v99
    v_fma_f32 v9, v73, v100, v9
    v_mul_f32 v10, v10, v99
    v_fma_f32 v10, v74, v100, v10
    v_mul_f32 v11, v11, v99
    v_fma_f32 v11, v75, v100, v11
    v_mul_f32 v12, v12, v99
    v_fma_f32 v12, v76, v100, v12
    v_mul_f32 v13, v13, v99
    v_fma_f32 v13, v77, v100, v13
    v_mul_f32 v14, v14, v99
    v_fma_f32 v14, v78, v100, v14
    v_mul_f32 v15, v15, v99
    v_fma_f32 v15, v79, v100, v15
    s_add_u32 s41, s41, 8
    s_cmp_lt_u32 s41, s39
    s_cbranch_scc1 K2_BATCH
    v_rcp_f32 v100, v97
    s_nop 0
    v_mul_f32 v8, v8, v100
    v_mul_f32 v9, v9, v100
    v_mul_f32 v10, v10, v100
    v_mul_f32 v11, v11, v100
    v_mul_f32 v12, v12, v100
    v_mul_f32 v13, v13, v100
    v_mul_f32 v14, v14, v100
    v_mul_f32 v15, v15, v100
    v_cvt_pk_bf16_f32 v16, v8, v9
    v_cvt_pk_bf16_f32 v17, v10, v11
    v_cvt_pk_bf16_f32 v18, v12, v13
    v_cvt_pk_bf16_f32 v19, v14, v15
    v_lshrrev_b32 v101, 1, v103
    s_lshl_b32 s45, s38, 14
    s_nop 4
    buffer_store_dwordx4 v[16:19], v101, s[28:31], s45 offen
K2_EXIT:
    s_waitcnt vmcnt(0)
    s_endpgm
    .section .rodata,"a"
    .p2align 6
    .amdhsa_kernel standalone__paged_block_table_kv_pagedattention__sampling_kernel
      .amdhsa_next_free_vgpr 160
      .amdhsa_next_free_sgpr 80
      .amdhsa_accum_offset 160
      .amdhsa_group_segment_fixed_size 0
      .amdhsa_kernarg_size 64
      .amdhsa_user_sgpr_count 2
      .amdhsa_user_sgpr_kernarg_segment_ptr 1
      .amdhsa_system_sgpr_workgroup_id_x 1
    .end_amdhsa_kernel
    .section .rodata,"a"
    .p2align 6
    .amdhsa_kernel standalone__paged_block_table_kv_pagedattention__sampling_combine_kernel
      .amdhsa_next_free_vgpr 114
      .amdhsa_next_free_sgpr 80
      .amdhsa_accum_offset 116
      .amdhsa_group_segment_fixed_size 0
      .amdhsa_kernarg_size 64
      .amdhsa_user_sgpr_count 2
      .amdhsa_user_sgpr_kernarg_segment_ptr 1
      .amdhsa_system_sgpr_workgroup_id_x 1
    .end_amdhsa_kernel
```
